```python
import torch

def _softmax(x, axis=-1):
    return torch.softmax(x, dim=axis)
def _gelu(x):
    return torch.nn.functional.gelu(x, approximate="tanh")
def _silu(x):
    return torch.nn.functional.silu(x)
def _sigmoid(x):
    return torch.sigmoid(x)
def _layernorm(x, axis=-1, eps=1e-5):
    m = x.mean(dim=axis, keepdim=True)
    v = x.var(dim=axis, keepdim=True, unbiased=False)
    return (x - m) / torch.sqrt(v + eps)
def _scatter_add(tgt, idx, src, axis=0):
    return tgt.clone().index_add_(axis, idx, src)
def _segment_sum(src, seg, n):
    out = torch.zeros((n,) + src.shape[1:], dtype=src.dtype)
    return out.index_add_(0, seg, src)
def _pad(x, pw):
    flat = tuple(v for pair in reversed(pw) for v in pair)
    return torch.nn.functional.pad(x, flat)

kernel_name = 'gated_mix__sliding_block_cached__glu_gated_geglu__decode'

def setup_inputs():

    _w = (lambda a: (lambda t: t.to(torch.bfloat16) if t.is_floating_point() else t)(torch.as_tensor(a)))
    def _A_setup():
        B, Sq, D = 1, 1, 640
        Hq, Hkv, Sk, Dh = 32, 32, 4096, 192
        assert Hq % Hkv == 0, (Hq, Hkv)
        return {
            "x": _w((lambda *s: torch.randn(*s, dtype=torch.bfloat16) * 0.05)(B, Sq, D)),
            "k_cache": _w((lambda *s: torch.randn(*s, dtype=torch.bfloat16) * 6.4)(B, Hkv, Sk, Dh)),
            "v_cache": _w((lambda *s: torch.randn(*s, dtype=torch.bfloat16) * 0.05)(B, Hkv, Sk, Dh)),
            "wq": _w((lambda *s: torch.randn(*s, dtype=torch.bfloat16) * 6.4)(D, Hq * Dh) * (D ** -0.5)),
            "wo": _w((lambda *s: torch.randn(*s, dtype=torch.bfloat16) * 0.05)(Hq * Dh, D) * ((Hq * Dh) ** -0.5)),
        }
    _A_in = _A_setup()

    def _B_setup():
        B, S, Dm, Df = 1, 1, 640, 1536
        return {
            "x": _w((lambda *s: torch.randn(*s, dtype=torch.bfloat16) * 0.05)(B, S, Dm)),
            "w_gate": _w((lambda *s: torch.randn(*s, dtype=torch.bfloat16) * 0.8)(Dm, Df) * (Dm ** -0.5)),
            "w_up": _w((lambda *s: torch.randn(*s, dtype=torch.bfloat16) * 0.8)(Dm, Df) * (Dm ** -0.5)),
            "w_down": _w((lambda *s: torch.randn(*s, dtype=torch.bfloat16) * 0.8)(Df, Dm) * (Df ** -0.5)),
        }
    _B_in = _B_setup()

    return {
        "A_x": _A_in["x"],
        "A_k_cache": _A_in["k_cache"],
        "A_v_cache": _A_in["v_cache"],
        "A_wq": _A_in["wq"],
        "A_wo": _A_in["wo"],
        "B_x": _B_in["x"],
        "B_w_gate": _B_in["w_gate"],
        "B_w_up": _B_in["w_up"],
        "B_w_down": _B_in["w_down"],
        "gate_w": _w((lambda *s: torch.randn(*s, dtype=torch.bfloat16) * 0.05)(640) * 16.0),
    }

def reference(A_x, A_k_cache, A_v_cache, A_wq, A_wo, B_x, B_w_gate, B_w_up, B_w_down, gate_w):
    def _A_ref(x, k_cache, v_cache, wq, wo):
        B, Sq, D = x.shape
        Hq, Dh = 32, 192
        Hkv, Sk = k_cache.shape[1], k_cache.shape[2]
        W = min(4096, max(256, Sk // 4))
        rep = Hq // Hkv
        q = (lambda x, *d: x.permute(*d))((x @ wq).reshape(B, Sq, Hq, Dh), 0, 2, 1, 3)
        k = (lambda x, n, axis: torch.repeat_interleave(x, n, dim=axis))(k_cache[:, :, Sk - W:, :], rep, axis=1)
        v = (lambda x, n, axis: torch.repeat_interleave(x, n, dim=axis))(v_cache[:, :, Sk - W:, :], rep, axis=1)
        scores = torch.einsum("bhqd,bhkd->bhqk", q, k) * (Dh ** -0.5)
        p = _softmax(scores, axis=-1)
        o = torch.einsum("bhqk,bhkd->bhqd", p, v)
        return (lambda x, *d: x.permute(*d))(o, 0, 2, 1, 3).reshape(B, Sq, Hq * Dh) @ wo

    def _B_ref(x, w_gate, w_up, w_down):
        g = torch.einsum("bsd,df->bsf", x, w_gate)
        u = torch.einsum("bsd,df->bsf", x, w_up)
        h = _gelu(g) * u
        return torch.einsum("bsf,fd->bsd", h, w_down)

    x = A_x
    g = _sigmoid((x * gate_w).sum(-1, keepdims=True))
    a = _A_ref(x, A_k_cache, A_v_cache, A_wq, A_wo)
    b = _B_ref(x, B_w_gate, B_w_up, B_w_down)
    return g * a + (1 - g) * b
```

```asm
; @launch grid=(256,1,1) block=(512,1,1) lds=4608
.amdgcn_target "amdgcn-amd-amdhsa--gfx950"
.text
.globl gated_mix__sliding_block_cached__glu_gated_geglu__decode_kernel
.p2align 12
.fill 832, 4, 0xbf800000
.p2align 8
.type gated_mix__sliding_block_cached__glu_gated_geglu__decode_kernel,@function
gated_mix__sliding_block_cached__glu_gated_geglu__decode_kernel:
    s_load_dwordx16 s[16:31], s[0:1], 0
    s_load_dwordx8 s[32:39], s[0:1], 64
    s_load_dwordx2 s[40:41], s[0:1], 96
    s_cmp_ge_u32 s2, 256
    s_cbranch_scc1 L_end
    v_lshrrev_b32 v1, 6, v0
    v_and_b32 v0, 63, v0
    v_readfirstlane_b32 s3, v1
    s_and_b32 s4, s2, 7
    s_lshr_b32 s5, s2, 6
    s_lshl3_add_u32 s4, s5, s4
    s_bfe_u32 s5, s2, 0x30003
    v_lshrrev_b32 v1, 3, v0
    v_and_b32 v2, 7, v0
    v_lshlrev_b32 v3, 4, v2
    s_mov_b32 s43, 0
    s_getreg_b32 s46, hwreg(HW_REG_XCC_ID, 0, 3)
    s_cmp_ge_u32 s3, 5
    s_cbranch_scc1 L_kv
    s_setprio 1
    s_mul_i32 s7, s4, 3
    s_add_u32 s7, s7, s3
    s_movk_i32 s6, 0x3000
    s_cmp_lt_u32 s3, 3
    s_cselect_b32 s7, s7, s4
    s_cselect_b32 s6, s6, 0xc00
    s_mul_i32 s8, s5, 80
    v_mad_u32_u24 v5, v1, 10, s8
    v_mul_u32_u24 v4, s6, v5
    s_lshl_b32 s7, s7, 7
    v_add3_u32 v4, v4, v3, s7
    v_lshlrev_b32 v5, 1, v5
    s_cmp_ge_u32 s4, 24
    s_cselect_b32 s9, 3, 5
    s_lshl2_add_u32 s12, s5, s3
    s_cmp_eq_u32 s5, 7
    s_subb_u32 s12, s12, 0
    s_mul_i32 s13, s12, 43
    s_lshr_b32 s13, s13, 7
    s_mul_i32 s8, s13, 3
    s_sub_u32 s12, s12, s8
    s_movk_i32 s8, 10240
    v_mad_u32_u24 v22, v1, s8, v3
    s_lshl_b32 s10, s13, 7
    v_add_u32 v22, s10, v22
    s_cmp_lt_u32 s12, 2
    s_cselect_b32 s14, 2, 1
    s_cmp_ge_u32 s4, 24
    s_cselect_b32 s14, 1, s14
    s_cmp_lt_u32 s5, 6
    s_cselect_b32 s8, 4, 3
    s_cmp_ge_u32 s3, s8
    s_cselect_b32 s14, 0, s14
    s_cmp_ge_u32 s3, 3
    s_cbranch_scc1 L_gu0
    s_waitcnt lgkmcnt(0)
L_pld:
    global_load_dwordx4 v[24:27], v4, s[22:23] nt
    v_add_u32 v4, s6, v4
    global_load_dwordx4 v[28:31], v4, s[22:23] nt
    v_add_u32 v4, s6, v4
    global_load_dwordx4 v[32:35], v4, s[22:23] nt
    v_add_u32 v4, s6, v4
    global_load_dwordx4 v[36:39], v4, s[22:23] nt
    v_add_u32 v4, s6, v4
    global_load_dwordx4 v[40:43], v4, s[22:23] nt
    v_add_u32 v4, s6, v4
    global_load_dwordx4 v[44:47], v4, s[22:23] nt
    v_add_u32 v4, s6, v4
    global_load_dwordx4 v[48:51], v4, s[22:23] nt
    v_add_u32 v4, s6, v4
    global_load_dwordx4 v[16:19], v5, s[16:17]
    global_load_dword v20, v5, s[16:17] offset:16
    global_load_dwordx4 v[52:55], v4, s[22:23] nt
    v_add_u32 v4, s6, v4
    global_load_dwordx4 v[56:59], v4, s[22:23] nt
    v_add_u32 v4, s6, v4
    global_load_dwordx4 v[60:63], v4, s[22:23] nt
L_p_iss:
    s_setprio 0
    s_load_dword s42, s[40:41], 0
    s_barrier
    s_branch L_p
L_gu0:
    v_mul_u32_u24 v7, 20, v0
    s_cmp_eq_u32 s3, 3
    s_waitcnt lgkmcnt(0)
    s_cselect_b64 s[22:23], s[28:29], s[30:31]
    s_cbranch_scc1 L_nog1
    s_cmp_eq_u32 s2, 192
    s_cbranch_scc1 L_init
L_initd:
    global_load_dwordx4 v[72:75], v7, s[16:17]
    global_load_dword v76, v7, s[16:17] offset:16
    global_load_dwordx4 v[78:81], v7, s[34:35]
    global_load_dword v82, v7, s[34:35] offset:16
L_nog1:
    s_cmp_lt_u32 s4, 24
    s_cbranch_scc1 L_pld
    s_branch L_p_iss
L_kv:
    s_sub_u32 s6, s3, 5
    s_mov_b64 exec, 0
    s_cmp_eq_u32 s6, 1
    s_cbranch_scc1 L_t1
    s_cmp_eq_u32 s6, 2
    s_cbranch_scc1 L_t2
    s_branch L_t0
L_back:
    s_mov_b64 exec, -1
    s_mul_i32 s7, s4, 1572864
    s_mul_i32 s8, s5, 49152
    s_add_u32 s7, s7, s8
    s_lshl_b32 s8, s6, 7
    s_add_u32 s7, s7, s8
    s_add_u32 s7, s7, 1182720
    s_movk_i32 s8, 6144
    v_mad_u32_u24 v4, v1, s8, v3
    v_add_u32 v4, s7, v4
    v_mov_b32 v183, 0
    ds_write_b32 v183, v183 offset:1544
    s_waitcnt lgkmcnt(0)
    s_load_dword s42, s[40:41], 0
    s_barrier
    global_load_dwordx4 v[16:19], v4, s[18:19] offset:-3072 nt
    s_mul_i32 s45, s4, 3
    s_add_u32 s45, s45, s6
    global_load_dwordx4 v[20:23], v4, s[18:19] offset:-2688 nt
    s_lshl_b32 s45, s45, 11
    s_add_u32 s45, s45, 335872
    global_load_dwordx4 v[24:27], v4, s[18:19] offset:-2304 nt
    s_mul_i32 s8, s4, 10240
    s_lshl_b32 s10, s6, 11
    global_load_dwordx4 v[28:31], v4, s[18:19] offset:-1920 nt
    s_add_u32 s8, s8, s10
    s_add_u32 s8, s8, 4096
    global_load_dwordx4 v[32:35], v4, s[18:19] offset:-1536 nt
    v_lshl_add_u32 v5, v1, 8, v3
    v_add_u32 v5, s8, v5
    global_load_dwordx4 v[36:39], v4, s[18:19] offset:-1152 nt
    v_mov_b32 v12, 0xffff
    v_mov_b32 v13, 0
    global_load_dwordx4 v[40:43], v4, s[18:19] offset:-768 nt
    v_lshlrev_b64 v[12:13], v3, v[12:13]
    v_cmp_gt_u32 vcc, 4, v2
    global_load_dwordx4 v[44:47], v4, s[18:19] offset:-384 nt
    s_nop 1
    v_cndmask_b32 v8, 0, v12, vcc
    global_load_dwordx4 v[48:51], v4, s[18:19] offset:0 nt
    v_cndmask_b32 v9, 0, v13, vcc
    v_cndmask_b32 v10, v12, 0, vcc
    global_load_dwordx4 v[52:55], v4, s[18:19] offset:384 nt
    v_cndmask_b32 v11, v13, 0, vcc
    s_lshl4_add_u32 s8, s5, s45
    s_waitcnt vmcnt(9)
    global_load_dwordx4 v[56:59], v4, s[18:19] offset:768 nt
    v_bfe_u32 v176, v0, 4, 1
    v_lshl_add_u32 v7, v2, 7, s8
    s_waitcnt vmcnt(9)
    global_load_dwordx4 v[60:63], v4, s[18:19] offset:1152 nt
    s_lshr_b32 s10, s5, 2
    v_xor_b32 v6, s10, v176
    s_waitcnt vmcnt(9)
    global_load_dwordx4 v[64:67], v4, s[18:19] offset:1536 nt
    v_cmp_eq_u32 s[52:53], 1, v6
    v_lshl_add_u32 v6, v6, 10, v7
    s_waitcnt vmcnt(9)
    global_load_dwordx4 v[68:71], v4, s[18:19] offset:1920 nt
    v_lshrrev_b32 v177, 5, v0
    v_lshl_add_u32 v177, v177, 1, v176
    s_waitcnt vmcnt(9)
    global_load_dwordx4 v[72:75], v4, s[18:19] offset:2304 nt
    v_and_b32 v176, 1, v1
    v_lshl_add_u32 v177, v176, 2, v177
    s_waitcnt vmcnt(9)
    global_load_dwordx4 v[76:79], v4, s[18:19] offset:2688 nt
    s_lshl_b32 s8, s6, 7
    v_add_u32 v178, s8, v3
    s_waitcnt vmcnt(9)
    global_load_dwordx4 v[80:83], v4, s[20:21] offset:-3072 nt
    v_lshl_add_u32 v177, v177, 1, v178
    s_lshl_b32 s8, s6, 9
    s_waitcnt vmcnt(9)
    global_load_dwordx4 v[84:87], v4, s[20:21] offset:-2688 nt
    v_lshrrev_b32 v176, 2, v2
    v_lshlrev_b32 v182, 6, v1
    s_waitcnt vmcnt(9)
    global_load_dwordx4 v[88:91], v4, s[20:21] offset:-2304 nt
    v_add_u32 v182, s8, v182
    v_lshl_add_u32 v179, v176, 5, v182
    global_load_dwordx4 v[144:147], v5, s[40:41] sc1
    global_load_dwordx4 v[148:151], v5, s[40:41] offset:128 sc1
    v_lshlrev_b32 v180, 3, v0
    v_add_u32 v181, s8, v180
    s_waitcnt vmcnt(9)
    global_load_dwordx4 v[92:95], v4, s[20:21] offset:-1920 nt
    v_mov_b32 v184, 1
    s_waitcnt vmcnt(9)
    global_load_dwordx4 v[96:99], v4, s[20:21] offset:-1536 nt
    s_nop 0
    s_waitcnt vmcnt(9)
    global_load_dwordx4 v[100:103], v4, s[20:21] offset:-1152 nt
    s_nop 0
    global_load_dwordx4 v[152:155], v5, s[40:41] sc1
L_t0:
    s_cbranch_execz L_back
    global_load_dwordx4 v[156:159], v5, s[40:41] offset:128 sc1
    s_nop 0
    s_waitcnt vmcnt(9)
    global_load_dwordx4 v[104:107], v4, s[20:21] offset:-768 nt
    s_nop 0
    s_waitcnt vmcnt(9)
    global_load_dwordx4 v[108:111], v4, s[20:21] offset:-384 nt
    s_nop 0
    s_waitcnt vmcnt(9)
    global_load_dwordx4 v[112:115], v4, s[20:21] offset:0 nt
    s_nop 0
    s_waitcnt lgkmcnt(0)
    s_add_u32 s42, s42, 0x01010101
    s_branch L_kv2
L_p:
    s_mov_b64 exec, 0
    s_cmp_eq_u32 s3, 0
    s_cbranch_scc1 L_t3
    s_cmp_eq_u32 s3, 1
    s_cbranch_scc1 L_t4
    s_cmp_eq_u32 s3, 2
    s_cbranch_scc1 L_t5
    s_cmp_eq_u32 s3, 3
    s_cbranch_scc1 L_t6
    s_cmp_eq_u32 s3, 4
    s_cbranch_scc1 L_t7
L_t7:
L_t6:
L_back2:
    s_mov_b64 exec, -1
    v_mov_b32 v12, 0xffff
    v_mov_b32 v13, 0
    v_lshlrev_b64 v[12:13], v3, v[12:13]
    v_cmp_gt_u32 vcc, 4, v2
    s_nop 1
    v_cndmask_b32 v8, 0, v12, vcc
    v_cndmask_b32 v9, 0, v13, vcc
    v_cndmask_b32 v10, v12, 0, vcc
    v_cndmask_b32 v11, v13, 0, vcc
    v_bfe_u32 v7, v0, 4, 1
    v_lshl_add_u32 v7, v7, 7, v3
    s_waitcnt lgkmcnt(0)
    s_add_u32 s42, s42, 0x01010101
    s_mul_i32 s44, s4, 10240
    s_add_u32 s44, s44, 4096
    s_cmp_ge_u32 s3, s9
    s_cbranch_scc1 L_p_done
    s_lshl_b32 s47, s46, 24
    s_xor_b32 s47, s47, s42
    s_lshl3_add_u32 s8, s3, s5
    s_lshl_b32 s8, s8, 8
    s_add_u32 s8, s8, s44
    v_add_u32 v6, s8, v7
    s_mov_b32 s10, 0x01000100
    s_mov_b32 s11, 0x03020302
    s_waitcnt vmcnt(3)
    v_perm_b32 v21, v16, v16, s10
    v_and_b32 v120, v21, v8
    v_and_b32 v121, v21, v9
    v_and_b32 v122, v21, v10
    v_and_b32 v123, v21, v11
    v_perm_b32 v21, v16, v16, s11
    v_and_b32 v124, v21, v8
    v_and_b32 v125, v21, v9
    v_and_b32 v126, v21, v10
    v_and_b32 v127, v21, v11
    v_perm_b32 v21, v17, v17, s10
    v_and_b32 v128, v21, v8
    v_and_b32 v129, v21, v9
    v_and_b32 v130, v21, v10
    v_and_b32 v131, v21, v11
    v_perm_b32 v21, v17, v17, s11
    v_and_b32 v132, v21, v8
    v_and_b32 v133, v21, v9
    v_and_b32 v134, v21, v10
    v_and_b32 v135, v21, v11
    v_perm_b32 v21, v18, v18, s10
    v_and_b32 v136, v21, v8
    v_and_b32 v137, v21, v9
    v_and_b32 v138, v21, v10
    v_and_b32 v139, v21, v11
    v_perm_b32 v21, v18, v18, s11
    v_and_b32 v140, v21, v8
    v_and_b32 v141, v21, v9
    v_and_b32 v142, v21, v10
    v_and_b32 v143, v21, v11
    v_perm_b32 v21, v19, v19, s10
    v_and_b32 v144, v21, v8
    v_and_b32 v145, v21, v9
    v_and_b32 v146, v21, v10
    v_and_b32 v147, v21, v11
    v_perm_b32 v21, v19, v19, s11
    v_and_b32 v148, v21, v8
    v_and_b32 v149, v21, v9
    v_and_b32 v150, v21, v10
    v_and_b32 v151, v21, v11
    v_perm_b32 v21, v20, v20, s10
    v_and_b32 v152, v21, v8
    v_and_b32 v153, v21, v9
    v_and_b32 v154, v21, v10
    v_and_b32 v155, v21, v11
    v_perm_b32 v21, v20, v20, s11
    v_and_b32 v156, v21, v8
    v_and_b32 v157, v21, v9
    v_and_b32 v158, v21, v10
    v_and_b32 v159, v21, v11
    v_mfma_f32_16x16x32_bf16 v[12:15], v[120:123], v[24:27], 0
    v_mfma_f32_16x16x32_bf16 v[12:15], v[124:127], v[28:31], v[12:15]
    v_mfma_f32_16x16x32_bf16 v[12:15], v[128:131], v[32:35], v[12:15]
    v_mfma_f32_16x16x32_bf16 v[12:15], v[132:135], v[36:39], v[12:15]
    v_mfma_f32_16x16x32_bf16 v[12:15], v[136:139], v[40:43], v[12:15]
    v_mfma_f32_16x16x32_bf16 v[12:15], v[140:143], v[44:47], v[12:15]
    v_mfma_f32_16x16x32_bf16 v[12:15], v[144:147], v[48:51], v[12:15]
    s_waitcnt vmcnt(2)
    v_mfma_f32_16x16x32_bf16 v[12:15], v[148:151], v[52:55], v[12:15]
    s_waitcnt vmcnt(1)
    v_mfma_f32_16x16x32_bf16 v[12:15], v[152:155], v[56:59], v[12:15]
    s_waitcnt vmcnt(0)
    v_mfma_f32_16x16x32_bf16 v[12:15], v[156:159], v[60:63], v[12:15]
    s_nop 7
    v_permlane32_swap_b32 v12, v16
    v_permlane32_swap_b32 v13, v17
    v_permlane32_swap_b32 v14, v18
    v_permlane32_swap_b32 v15, v19
    v_add_f32_dpp v12, v16, v12 row_ror:8 row_mask:0xf bank_mask:0xf
    v_add_f32_dpp v13, v17, v13 row_ror:8 row_mask:0xf bank_mask:0xf
    v_add_f32_dpp v14, v18, v14 row_ror:8 row_mask:0xf bank_mask:0xf
    v_add_f32_dpp v15, v19, v15 row_ror:8 row_mask:0xf bank_mask:0xf
    v_mov_b32_sdwa v12, s47 dst_sel:BYTE_0 dst_unused:UNUSED_PRESERVE src0_sel:BYTE_0
    v_mov_b32_sdwa v13, s47 dst_sel:BYTE_0 dst_unused:UNUSED_PRESERVE src0_sel:BYTE_1
    v_mov_b32_sdwa v14, s47 dst_sel:BYTE_0 dst_unused:UNUSED_PRESERVE src0_sel:BYTE_2
    v_mov_b32_sdwa v15, s47 dst_sel:BYTE_0 dst_unused:UNUSED_PRESERVE src0_sel:BYTE_3
    s_mov_b64 exec, 0x00ff00ff
    global_store_dwordx4 v6, v[12:15], s[40:41]
    s_mov_b64 exec, -1
L_p_done:
    v_mov_b32 v21, 0
    s_cmp_eq_u32 s14, 0
    s_cbranch_scc1 L_p_exit
    s_mul_i32 s15, s4, 3
    s_add_u32 s15, s15, s12
    s_mul_i32 s8, s15, 81920
    s_add_u32 s8, s8, 3840
    v_add_u32 v4, s8, v22
    s_lshl4_add_u32 s8, s4, s12
    s_mul_i32 s8, s8, 5120
    v_add_u32 v66, s8, v22
    s_lshl_b32 s8, s15, 11
    s_add_u32 s8, s8, 335872
    v_lshl_add_u32 v5, v0, 4, s8
    s_mul_i32 s8, s13, 2048
    s_add_u32 s8, s8, 655360
    v_lshrrev_b32 v65, 4, v0
    v_mul_u32_u24 v6, 256, v65
    v_and_b32 v64, 15, v0
    v_lshl_add_u32 v6, v64, 2, v6
    v_add_u32 v6, s8, v6
    v_and_b32 v68, 1, v65
    v_lshl_add_u32 v68, v68, 3, v3
    v_lshrrev_b32 v69, 5, v0
    v_lshl_add_u32 v68, v69, 2, v68
    s_lshl_b32 s8, s13, 7
    v_add_u32 v68, s8, v68
    v_mov_b32 v69, 0x42be0000
    v_and_b32 v70, 1, v1
    v_cvt_f32_u32 v70, v70
    v_mov_b32 v71, v70
    s_mov_b32 s54, 0x00ff00ff
    s_mov_b32 s55, s54
    s_mov_b32 s58, 0x01ff01ff
    s_mov_b32 s59, s58
    s_mov_b32 s50, 0xffff0000
    s_lshl_b32 s8, s12, 7
    s_add_u32 s8, s8, s44
    s_add_u32 s8, s8, 6144
    v_lshl_add_u32 v20, v1, 8, v3
    v_add_u32 v20, s8, v20
    s_lshl_b32 s8, s3, 8
    v_lshl_add_u32 v64, v64, 4, s8
    v_lshl_add_u32 v64, v65, 2, v64
    v_lshl_add_u32 v65, v1, 4, s8
    s_barrier
    ds_read_b64 v[22:23], v21 offset:1536
    global_load_dword v39, v21, s[40:41] offset:2048 sc1
    s_cmp_lg_u32 s14, 2
    s_cbranch_scc1 L_nogu
    global_load_dwordx4 v[24:27], v20, s[40:41] sc1
    global_load_dwordx4 v[28:31], v20, s[40:41] offset:2048 sc1
    s_nop 0
    global_load_dwordx4 v[104:107], v66, s[32:33] offset:0 nt
    s_nop 0
    global_load_dwordx4 v[108:111], v66, s[32:33] offset:1280 nt
    s_nop 0
    global_load_dwordx4 v[112:115], v66, s[32:33] offset:2560 nt
    s_nop 0
    global_load_dwordx4 v[116:119], v66, s[32:33] offset:3840 nt
L_nogu:
    s_nop 0
    global_load_dwordx4 v[72:75], v4, s[24:25] offset:-3840 nt
    s_barrier
    s_nop 0
    global_load_dwordx4 v[76:79], v4, s[24:25] offset:-2560 nt
L_t1:
    s_cbranch_execz L_back
    s_nop 0
    global_load_dwordx4 v[80:83], v4, s[24:25] offset:-1280 nt
    s_nop 0
    global_load_dwordx4 v[84:87], v4, s[24:25] offset:0 nt
    s_nop 0
    global_load_dwordx4 v[88:91], v4, s[24:25] offset:1280 nt
    s_nop 0
    global_load_dwordx4 v[132:135], v5, s[40:41] sc1
    global_load_dwordx4 v[136:139], v5, s[40:41] offset:1024 sc1
    s_nop 0
    global_load_dwordx4 v[92:95], v4, s[24:25] offset:2560 nt
    s_nop 0
    global_load_dwordx4 v[96:99], v4, s[24:25] offset:3840 nt
    v_add_u32 v4, 5120, v4
    global_load_dwordx4 v[100:103], v4, s[24:25] offset:0 nt
    s_cbranch_scc1 L_o_wait
    s_waitcnt vmcnt(14)
L_gu_chk:
    v_xor_b32_sdwa v44, v27, s42 dst_sel:DWORD dst_unused:UNUSED_PAD src0_sel:BYTE_0 src1_sel:BYTE_3
    v_xor_b32_sdwa v45, v31, s42 dst_sel:DWORD dst_unused:UNUSED_PAD src0_sel:BYTE_0 src1_sel:BYTE_3
    v_cmpx_eq_u32_sdwa vcc, v24, s42 src0_sel:BYTE_0 src1_sel:BYTE_0
    v_cmpx_eq_u32_sdwa vcc, v25, s42 src0_sel:BYTE_0 src1_sel:BYTE_1
    v_cmpx_eq_u32_sdwa vcc, v26, s42 src0_sel:BYTE_0 src1_sel:BYTE_2
    v_cmpx_eq_u32_sdwa vcc, v28, s42 src0_sel:BYTE_0 src1_sel:BYTE_0
    v_cmpx_eq_u32_sdwa vcc, v29, s42 src0_sel:BYTE_0 src1_sel:BYTE_1
    v_cmpx_eq_u32_sdwa vcc, v30, s42 src0_sel:BYTE_0 src1_sel:BYTE_2
    v_cmpx_gt_u32 vcc, 8, v44
    v_cmpx_gt_u32 vcc, 8, v45
    s_cmp_eq_u64 exec, -1
    s_mov_b64 exec, -1
    s_cbranch_scc1 L_gu_ok
    global_load_dwordx4 v[24:27], v20, s[40:41] sc1
    global_load_dwordx4 v[28:31], v20, s[40:41] offset:2048 sc1
    s_and_b32 s8, s43, 3
    s_cmp_lg_u32 s8, 3
    s_cbranch_scc1 L_gu_nowb
    buffer_wbl2 sc1
L_gu_nowb:
    s_add_u32 s43, s43, 1
    s_cmp_lt_u32 s43, 1048576
    s_waitcnt vmcnt(0)
    s_cbranch_scc1 L_gu_chk
L_gu_ok:
    v_cmp_ne_u32 s[48:49], s46, v44
    s_cmp_eq_u64 s[48:49], 0
    s_cbranch_scc1 L_gu_loc
    buffer_wbl2 sc1
L_gu_loc:
    s_movk_i32 s8, 0xff00
    v_and_b32 v24, s8, v24
    v_and_b32 v25, s8, v25
    v_and_b32 v26, s8, v26
    v_and_b32 v27, s8, v27
    v_and_b32 v28, s8, v28
    v_and_b32 v29, s8, v29
    v_and_b32 v30, s8, v30
    v_and_b32 v31, s8, v31
    v_add_f32_dpp v40, v24, v24 row_ror:8 row_mask:0xf bank_mask:0x3
    v_add_f32_dpp v41, v25, v25 row_ror:8 row_mask:0xf bank_mask:0x3
    v_add_f32_dpp v42, v26, v26 row_ror:8 row_mask:0xf bank_mask:0x3
    v_add_f32_dpp v43, v27, v27 row_ror:8 row_mask:0xf bank_mask:0x3
    v_add_f32_dpp v40, v28, v28 row_ror:8 row_mask:0xf bank_mask:0xc
    v_add_f32_dpp v41, v29, v29 row_ror:8 row_mask:0xf bank_mask:0xc
    v_add_f32_dpp v42, v30, v30 row_ror:8 row_mask:0xf bank_mask:0xc
    v_add_f32_dpp v43, v31, v31 row_ror:8 row_mask:0xf bank_mask:0xc
    v_permlane16_swap_b32 v40, v41
    s_nop 0
    v_permlane16_swap_b32 v42, v43
    v_add_f32 v40, v40, v41
    v_add_f32 v42, v42, v43
    s_nop 1
    v_permlane32_swap_b32 v40, v42
    v_add_f32 v40, v40, v42
    v_cvt_pk_bf16_f32 v40, v40, v40
    v_and_b32 v40, 0xffff0000, v40
    v_mul_f32 v41, v40, v40
    v_mul_f32 v41, 0x3d372713, v41
    v_fma_f32 v41, v41, v40, v40
    v_mul_f32 v41, 0xc0135761, v41
    v_exp_f32 v41, v41
    s_nop 0
    v_add_f32 v41, 1.0, v41
    v_rcp_f32 v41, v41
    s_nop 0
    v_mul_f32 v41, v40, v41
    v_cvt_pk_bf16_f32 v41, v41, v41
    v_and_b32 v41, 0xffff0000, v41
    s_nop 1
    v_mul_f32_dpp v41, v40, v41 row_ror:8 row_mask:0xf bank_mask:0xf
    v_cvt_pk_bf16_f32 v41, v41, v41
    ds_write_b32 v64, v41 offset:3584
    ds_read_b128 v[44:47], v65 offset:3584
    s_waitcnt lgkmcnt(0)
    v_and_b32 v48, v44, v8
    v_and_b32 v49, v44, v9
    v_and_b32 v50, v44, v10
    v_and_b32 v51, v44, v11
    v_and_b32 v52, v45, v8
    v_and_b32 v53, v45, v9
    v_and_b32 v54, v45, v10
    v_and_b32 v55, v45, v11
    v_and_b32 v56, v46, v8
    v_and_b32 v57, v46, v9
    v_and_b32 v58, v46, v10
    v_and_b32 v59, v46, v11
    v_and_b32 v60, v47, v8
    v_and_b32 v61, v47, v9
    v_and_b32 v62, v47, v10
    v_and_b32 v63, v47, v11
    s_waitcnt vmcnt(10)
    v_mfma_f32_16x16x32_bf16 v[16:19], v[48:51], v[104:107], 0
    v_mfma_f32_16x16x32_bf16 v[16:19], v[52:55], v[108:111], v[16:19]
    v_mfma_f32_16x16x32_bf16 v[16:19], v[56:59], v[112:115], v[16:19]
    v_mfma_f32_16x16x32_bf16 v[16:19], v[60:63], v[116:119], v[16:19]
    s_waitcnt lgkmcnt(0)
    s_nop 6
    v_permlane32_swap_b32 v16, v18
    v_permlane32_swap_b32 v17, v19
    s_nop 0
    v_fmac_f32_dpp v70, v16, v23 quad_perm:[0,1,2,3] row_mask:0xf bank_mask:0x3
    v_fmac_f32_dpp v71, v17, v23 quad_perm:[0,1,2,3] row_mask:0xf bank_mask:0x3
    s_nop 0
    v_fmac_f32_dpp v70, v18, v23 row_ror:8 row_mask:0xf bank_mask:0x3
    v_fmac_f32_dpp v71, v19, v23 row_ror:8 row_mask:0xf bank_mask:0x3
L_o_wait:
    s_waitcnt lgkmcnt(0)
    s_mov_b32 s9, 0
    s_waitcnt vmcnt(10)
L_flag:
    v_cmp_ne_u32 vcc, s42, v39
    s_cbranch_vccz L_o_first
    global_load_dword v39, v21, s[40:41] offset:2048 sc1
    s_add_u32 s43, s43, 1
    s_cmp_lt_u32 s43, 1048576
    s_waitcnt vmcnt(0)
    s_cbranch_scc1 L_flag
L_o_first:
    s_waitcnt vmcnt(3)
    s_branch L_o_in
L_o_loop:
    global_load_dwordx4 v[132:135], v5, s[40:41] sc1
    global_load_dwordx4 v[136:139], v5, s[40:41] offset:1024 sc1
    s_add_u32 s9, s9, 1
    s_cmp_ge_u32 s9, 1048576
    s_cbranch_scc1 L_o_bail
    s_waitcnt vmcnt(0)
L_o_in:
    v_max_f32_dpp v36, v134, v134 quad_perm:[1,0,3,2] row_mask:0xf bank_mask:0xf
    v_cmp_ne_u32 s[56:57], s42, v135
    v_cmp_ne_u32 vcc, s42, v139
    v_max_f32_dpp v36, v36, v36 quad_perm:[2,3,0,1] row_mask:0xf bank_mask:0xf
    s_or_b64 s[56:57], s[56:57], vcc
    s_cbranch_scc1 L_o_loop
    v_max_f32_dpp v36, v36, v36 row_half_mirror row_mask:0xf bank_mask:0xf
    v_sub_f32 v36, v134, v36
    v_exp_f32 v36, v36
    v_lshlrev_b32 v124, 16, v136
    v_and_b32 v125, s50, v136
    v_lshlrev_b32 v126, 16, v137
    v_and_b32 v127, s50, v137
    v_mov_b32_dpp v38, v36 row_half_mirror row_mask:0xf bank_mask:0xf
    v_lshlrev_b32 v120, 16, v132
    v_and_b32 v121, s50, v132
    v_lshlrev_b32 v122, 16, v133
    v_and_b32 v123, s50, v133
    v_mul_f32 v40, v120, v36
    v_mul_f32 v41, v121, v36
    v_mul_f32 v42, v122, v36
    v_mul_f32 v43, v123, v36
    v_fmac_f32_dpp v40, v124, v38 row_half_mirror row_mask:0xf bank_mask:0xf
    v_fmac_f32_dpp v41, v125, v38 row_half_mirror row_mask:0xf bank_mask:0xf
    v_fmac_f32_dpp v42, v126, v38 row_half_mirror row_mask:0xf bank_mask:0xf
    v_fmac_f32_dpp v43, v127, v38 row_half_mirror row_mask:0xf bank_mask:0xf
    v_add_f32_dpp v40, v40, v40 quad_perm:[1,0,3,2] row_mask:0xf bank_mask:0xf
    v_add_f32_dpp v41, v41, v41 quad_perm:[1,0,3,2] row_mask:0xf bank_mask:0xf
    v_add_f32_dpp v42, v42, v42 quad_perm:[1,0,3,2] row_mask:0xf bank_mask:0xf
    v_add_f32_dpp v43, v43, v43 quad_perm:[1,0,3,2] row_mask:0xf bank_mask:0xf
    v_add_f32_dpp v40, v40, v40 quad_perm:[2,3,0,1] row_mask:0xf bank_mask:0xf
    v_add_f32_dpp v41, v41, v41 quad_perm:[2,3,0,1] row_mask:0xf bank_mask:0xf
    v_add_f32_dpp v42, v42, v42 quad_perm:[2,3,0,1] row_mask:0xf bank_mask:0xf
    v_add_f32_dpp v43, v43, v43 quad_perm:[2,3,0,1] row_mask:0xf bank_mask:0xf
    v_cvt_pk_bf16_f32 v40, v40, v40
    v_cvt_pk_bf16_f32 v41, v41, v41
    v_cvt_pk_bf16_f32 v42, v42, v42
    v_cvt_pk_bf16_f32 v43, v43, v43
    v_and_b32 v144, v40, v8
    v_and_b32 v145, v40, v9
    v_and_b32_dpp v146, v40, v10 row_half_mirror row_mask:0xf bank_mask:0xf
    v_and_b32_dpp v147, v40, v11 row_half_mirror row_mask:0xf bank_mask:0xf
    v_and_b32 v148, v41, v8
    v_and_b32 v149, v41, v9
    v_and_b32_dpp v150, v41, v10 row_half_mirror row_mask:0xf bank_mask:0xf
    v_and_b32_dpp v151, v41, v11 row_half_mirror row_mask:0xf bank_mask:0xf
    v_mfma_f32_16x16x32_bf16 v[12:15], v[144:147], v[72:75], 0
    v_and_b32 v152, v42, v8
    v_and_b32 v153, v42, v9
    v_and_b32_dpp v154, v42, v10 row_half_mirror row_mask:0xf bank_mask:0xf
L_t2:
    s_cbranch_execz L_back
    v_and_b32_dpp v155, v42, v11 row_half_mirror row_mask:0xf bank_mask:0xf
    v_mfma_f32_16x16x32_bf16 v[12:15], v[148:151], v[76:79], v[12:15]
    v_and_b32 v156, v43, v8
    v_and_b32 v157, v43, v9
    v_and_b32_dpp v158, v43, v10 row_half_mirror row_mask:0xf bank_mask:0xf
    v_and_b32_dpp v159, v43, v11 row_half_mirror row_mask:0xf bank_mask:0xf
    v_mfma_f32_16x16x32_bf16 v[12:15], v[152:155], v[80:83], v[12:15]
    v_and_b32_dpp v160, v40, v8 row_half_mirror row_mask:0xf bank_mask:0xf
    v_and_b32_dpp v161, v40, v9 row_half_mirror row_mask:0xf bank_mask:0xf
    v_and_b32 v162, v40, v10
    v_and_b32 v163, v40, v11
    v_mfma_f32_16x16x32_bf16 v[12:15], v[156:159], v[84:87], v[12:15]
    v_and_b32_dpp v164, v41, v8 row_half_mirror row_mask:0xf bank_mask:0xf
    v_and_b32_dpp v165, v41, v9 row_half_mirror row_mask:0xf bank_mask:0xf
    v_and_b32 v166, v41, v10
    v_and_b32 v167, v41, v11
    v_mfma_f32_16x16x32_bf16 v[12:15], v[160:163], v[88:91], v[12:15]
    v_and_b32_dpp v168, v42, v8 row_half_mirror row_mask:0xf bank_mask:0xf
    v_and_b32_dpp v169, v42, v9 row_half_mirror row_mask:0xf bank_mask:0xf
    v_and_b32 v170, v42, v10
    v_and_b32 v171, v42, v11
    v_and_b32_dpp v172, v43, v8 row_half_mirror row_mask:0xf bank_mask:0xf
    v_and_b32_dpp v173, v43, v9 row_half_mirror row_mask:0xf bank_mask:0xf
    v_and_b32 v174, v43, v10
    v_and_b32 v175, v43, v11
    v_mul_f32 v39, v138, v36
    s_waitcnt vmcnt(2)
    v_mfma_f32_16x16x32_bf16 v[12:15], v[164:167], v[92:95], v[12:15]
    v_add_f32_dpp v39, v39, v39 quad_perm:[1,0,3,2] row_mask:0xf bank_mask:0xf
    s_waitcnt vmcnt(1)
    v_mfma_f32_16x16x32_bf16 v[12:15], v[168:171], v[96:99], v[12:15]
    v_add_f32_dpp v39, v39, v39 quad_perm:[2,3,0,1] row_mask:0xf bank_mask:0xf
    s_waitcnt vmcnt(0)
    v_mfma_f32_16x16x32_bf16 v[12:15], v[172:175], v[100:103], v[12:15]
    v_add_f32_dpp v39, v39, v39 row_half_mirror row_mask:0xf bank_mask:0xf
    v_rcp_f32 v39, v39
    s_nop 0
    v_mul_f32 v39, v22, v39
    s_nop 3
    v_permlane32_swap_b32 v12, v14
    v_permlane32_swap_b32 v13, v15
    s_nop 0
    v_add_f32_dpp v12, v14, v12 row_ror:8 row_mask:0xf bank_mask:0xf
    v_add_f32_dpp v13, v15, v13 row_ror:8 row_mask:0xf bank_mask:0xf
L_o_bail:
    s_mov_b64 exec, s[54:55]
    v_fmac_f32 v70, v12, v39
    v_fmac_f32 v71, v13, v39
    s_mov_b64 exec, s[58:59]
    global_atomic_add_f32 v16, v6, v70, s[40:41] sc0 sc1
    global_atomic_add_f32 v17, v6, v71, s[40:41] offset:1024 sc0 sc1
    s_waitcnt vmcnt(0)
    v_mov_b32_dpp v18, v16 row_newbcast:8 row_mask:0xf bank_mask:0xf
    v_mov_b32_dpp v19, v17 row_newbcast:8 row_mask:0xf bank_mask:0xf
    v_add_f32 v16, v16, v70
    v_add_f32 v17, v17, v71
    s_mov_b64 exec, s[54:55]
    v_cmp_eq_f32 s[56:57], v19, v69
    v_cvt_pk_bf16_f32 v16, v16, v17
    v_cmpx_eq_f32 vcc, v18, v69
    s_cbranch_execz L_s0
    global_store_short v68, v16, s[36:37]
L_s0:
    s_mov_b64 exec, s[56:57]
    s_cbranch_execz L_s1
    global_store_short_d16_hi v68, v16, s[36:37] offset:2
    s_cmp_lg_u32 s13, 0
    s_cbranch_scc1 L_s1
    s_and_b64 exec, exec, 1
    s_cbranch_execz L_s1
    v_mov_b32 v17, s42
    global_store_dword v68, v17, s[40:41]
L_s1:
    s_endpgm
L_init:
    v_lshrrev_b32 v60, 2, v0
    v_mul_u32_u24 v60, 256, v60
    v_and_b32 v61, 3, v0
    v_lshl_add_u32 v60, v61, 4, v60
    v_add_u32 v60, 655360, v60
    v_mov_b32 v56, 0
    v_mov_b32 v57, 0
    v_mov_b32 v58, 0
    v_mov_b32 v59, 0
    global_store_dwordx4 v60, v[56:59], s[40:41] sc1
    v_add_u32 v60, 4096, v60
    global_store_dwordx4 v60, v[56:59], s[40:41] sc1
    v_add_u32 v60, 4096, v60
    global_store_dwordx4 v60, v[56:59], s[40:41] sc1
    v_add_u32 v60, 4096, v60
    global_store_dwordx4 v60, v[56:59], s[40:41] sc1
    v_add_u32 v60, 4096, v60
    global_store_dwordx4 v60, v[56:59], s[40:41] sc1
    s_branch L_initd
L_p_exit:
    s_cmp_lg_u32 s3, 4
    s_cbranch_scc1 L_x1
    s_cmp_lt_u32 s4, 24
    s_cbranch_scc1 L_g3
    s_waitcnt vmcnt(0)
    s_cmp_lg_u32 s2, 192
    s_cbranch_scc1 L_g3
    v_mov_b32 v30, s42
    s_mov_b64 exec, 1
    global_store_dword v21, v30, s[40:41] offset:2048 sc1
    s_mov_b64 exec, -1
L_g3:
    v_mov_b32 v30, 0
    s_mov_b32 s8, 0xffff0000
    v_lshlrev_b32 v32, 16, v72
    v_and_b32 v33, s8, v72
    v_lshlrev_b32 v34, 16, v78
    v_and_b32 v35, s8, v78
    v_pk_mul_f32 v[32:33], v[32:33], v[34:35]
    v_cvt_pk_bf16_f32 v32, v32, v33
    v_lshlrev_b32 v33, 16, v32
    v_and_b32 v32, s8, v32
    v_add_f32 v30, v30, v33
    v_add_f32 v30, v30, v32
    v_lshlrev_b32 v32, 16, v73
    v_and_b32 v33, s8, v73
    v_lshlrev_b32 v34, 16, v79
    v_and_b32 v35, s8, v79
    v_pk_mul_f32 v[32:33], v[32:33], v[34:35]
    v_cvt_pk_bf16_f32 v32, v32, v33
    v_lshlrev_b32 v33, 16, v32
    v_and_b32 v32, s8, v32
    v_add_f32 v30, v30, v33
    v_add_f32 v30, v30, v32
    v_lshlrev_b32 v32, 16, v74
    v_and_b32 v33, s8, v74
    v_lshlrev_b32 v34, 16, v80
    v_and_b32 v35, s8, v80
    v_pk_mul_f32 v[32:33], v[32:33], v[34:35]
    v_cvt_pk_bf16_f32 v32, v32, v33
    v_lshlrev_b32 v33, 16, v32
    v_and_b32 v32, s8, v32
    v_add_f32 v30, v30, v33
    v_add_f32 v30, v30, v32
    v_lshlrev_b32 v32, 16, v75
    v_and_b32 v33, s8, v75
    v_lshlrev_b32 v34, 16, v81
    v_and_b32 v35, s8, v81
    v_pk_mul_f32 v[32:33], v[32:33], v[34:35]
    v_cvt_pk_bf16_f32 v32, v32, v33
    v_lshlrev_b32 v33, 16, v32
    v_and_b32 v32, s8, v32
    v_add_f32 v30, v30, v33
    v_add_f32 v30, v30, v32
    v_lshlrev_b32 v32, 16, v76
    v_and_b32 v33, s8, v76
    v_lshlrev_b32 v34, 16, v82
    v_and_b32 v35, s8, v82
    v_pk_mul_f32 v[32:33], v[32:33], v[34:35]
    v_cvt_pk_bf16_f32 v32, v32, v33
    v_lshlrev_b32 v33, 16, v32
L_t3:
    s_cbranch_execz L_back2
    v_and_b32 v32, s8, v32
    v_add_f32 v30, v30, v33
    v_add_f32 v30, v30, v32
    s_nop 1
    v_add_f32_dpp v30, v30, v30 quad_perm:[1,0,3,2] row_mask:0xf bank_mask:0xf
    s_nop 1
    v_add_f32_dpp v30, v30, v30 quad_perm:[2,3,0,1] row_mask:0xf bank_mask:0xf
    s_nop 1
    v_add_f32_dpp v30, v30, v30 row_half_mirror row_mask:0xf bank_mask:0xf
    s_nop 1
    v_add_f32_dpp v30, v30, v30 row_ror:8 row_mask:0xf bank_mask:0xf
    v_mov_b32 v31, v30
    s_nop 1
    v_permlane16_swap_b32 v30, v31
    v_add_f32 v30, v30, v31
    v_mov_b32 v31, v30
    s_nop 1
    v_permlane32_swap_b32 v30, v31
    v_add_f32 v30, v30, v31
    v_cvt_pk_bf16_f32 v30, v30, v30
    v_and_b32 v30, 0xffff0000, v30
    v_mul_f32 v30, 0xbfb8aa3b, v30
    v_exp_f32 v30, v30
    s_nop 0
    v_add_f32 v30, 1.0, v30
    v_rcp_f32 v30, v30
    s_nop 0
    v_cvt_pk_bf16_f32 v30, v30, v30
    v_and_b32 v30, 0xffff0000, v30
    v_sub_f32 v31, 1.0, v30
    v_cvt_pk_bf16_f32 v31, v31, v31
    v_and_b32 v31, 0xffff0000, v31
    ds_write_b64 v21, v[30:31] offset:1536
    s_waitcnt lgkmcnt(0)
L_x1:
    s_barrier
    s_endpgm
L_kv2:
    s_waitcnt vmcnt(8)
    v_xor_b32_sdwa v164, v147, s42 dst_sel:DWORD dst_unused:UNUSED_PAD src0_sel:BYTE_0 src1_sel:BYTE_3
    v_xor_b32_sdwa v165, v151, s42 dst_sel:DWORD dst_unused:UNUSED_PAD src0_sel:BYTE_0 src1_sel:BYTE_3
    v_cmpx_eq_u32_sdwa vcc, v144, s42 src0_sel:BYTE_0 src1_sel:BYTE_0
    v_cmpx_eq_u32_sdwa vcc, v145, s42 src0_sel:BYTE_0 src1_sel:BYTE_1
    v_cmpx_eq_u32_sdwa vcc, v146, s42 src0_sel:BYTE_0 src1_sel:BYTE_2
    v_cmpx_eq_u32_sdwa vcc, v148, s42 src0_sel:BYTE_0 src1_sel:BYTE_0
    v_cmpx_eq_u32_sdwa vcc, v149, s42 src0_sel:BYTE_0 src1_sel:BYTE_1
    v_cmpx_eq_u32_sdwa vcc, v150, s42 src0_sel:BYTE_0 src1_sel:BYTE_2
    v_cmpx_gt_u32 vcc, 8, v164
    v_cmpx_gt_u32 vcc, 8, v165
    s_cmp_eq_u64 exec, -1
    s_mov_b64 exec, -1
    s_cbranch_scc1 L_q_ok
    s_add_u32 s43, s43, 1
    s_waitcnt vmcnt(3)
    v_mov_b64 v[144:145], v[152:153]
    v_mov_b64 v[146:147], v[154:155]
    v_mov_b64 v[148:149], v[156:157]
    v_mov_b64 v[150:151], v[158:159]
L_q_chk:
    v_xor_b32_sdwa v164, v147, s42 dst_sel:DWORD dst_unused:UNUSED_PAD src0_sel:BYTE_0 src1_sel:BYTE_3
    v_xor_b32_sdwa v165, v151, s42 dst_sel:DWORD dst_unused:UNUSED_PAD src0_sel:BYTE_0 src1_sel:BYTE_3
    v_cmpx_eq_u32_sdwa vcc, v144, s42 src0_sel:BYTE_0 src1_sel:BYTE_0
    v_cmpx_eq_u32_sdwa vcc, v145, s42 src0_sel:BYTE_0 src1_sel:BYTE_1
    v_cmpx_eq_u32_sdwa vcc, v146, s42 src0_sel:BYTE_0 src1_sel:BYTE_2
    v_cmpx_eq_u32_sdwa vcc, v148, s42 src0_sel:BYTE_0 src1_sel:BYTE_0
    v_cmpx_eq_u32_sdwa vcc, v149, s42 src0_sel:BYTE_0 src1_sel:BYTE_1
    v_cmpx_eq_u32_sdwa vcc, v150, s42 src0_sel:BYTE_0 src1_sel:BYTE_2
    v_cmpx_gt_u32 vcc, 8, v164
    v_cmpx_gt_u32 vcc, 8, v165
    s_cmp_eq_u64 exec, -1
    s_mov_b64 exec, -1
    s_cbranch_scc1 L_q_ok
    global_load_dwordx4 v[144:147], v5, s[40:41] sc1
    global_load_dwordx4 v[148:151], v5, s[40:41] offset:128 sc1
    s_and_b32 s8, s43, 3
    s_cmp_lg_u32 s8, 3
    s_cbranch_scc1 L_q_nowb
    buffer_wbl2 sc1
L_q_nowb:
    s_add_u32 s43, s43, 1
    s_cmp_lt_u32 s43, 1048576
    s_waitcnt vmcnt(0)
    s_cbranch_scc1 L_q_chk
L_q_ok:
    v_cmp_ne_u32 s[48:49], s46, v164
    s_cmp_eq_u64 s[48:49], 0
    s_cbranch_scc1 L_q_loc
    buffer_wbl2 sc1
L_q_loc:
    s_movk_i32 s8, 0xff00
    v_and_b32 v144, s8, v144
    v_and_b32 v145, s8, v145
    v_and_b32 v146, s8, v146
    v_and_b32 v147, s8, v147
    v_and_b32 v148, s8, v148
    v_and_b32 v149, s8, v149
    v_and_b32 v150, s8, v150
    v_and_b32 v151, s8, v151
    global_load_dwordx4 v[116:119], v4, s[20:21] offset:384 nt
    v_add_f32_dpp v160, v144, v144 row_ror:8 row_mask:0xf bank_mask:0x3
    v_add_f32_dpp v161, v145, v145 row_ror:8 row_mask:0xf bank_mask:0x3
    v_add_f32_dpp v162, v146, v146 row_ror:8 row_mask:0xf bank_mask:0x3
    v_add_f32_dpp v163, v147, v147 row_ror:8 row_mask:0xf bank_mask:0x3
    v_add_f32_dpp v160, v148, v148 row_ror:8 row_mask:0xf bank_mask:0xc
    v_add_f32_dpp v161, v149, v149 row_ror:8 row_mask:0xf bank_mask:0xc
    v_add_f32_dpp v162, v150, v150 row_ror:8 row_mask:0xf bank_mask:0xc
    v_add_f32_dpp v163, v151, v151 row_ror:8 row_mask:0xf bank_mask:0xc
    v_permlane16_swap_b32 v160, v161
    s_nop 0
    v_permlane16_swap_b32 v162, v163
    v_add_f32 v160, v160, v161
    v_add_f32 v162, v162, v163
    s_nop 1
    v_permlane32_swap_b32 v160, v162
    v_add_f32 v160, v160, v162
    v_cvt_pk_bf16_f32 v160, v160, v160
    ds_write_b16 v177, v160 offset:1600
    ds_read_b128 v[12:15], v178 offset:1600
    s_waitcnt lgkmcnt(0)
    global_load_dwordx4 v[120:123], v4, s[20:21] offset:768 nt
    v_dot2_f32_bf16 v160, v16, v12, 0
    v_dot2_f32_bf16 v161, v20, v12, 0
    v_dot2_f32_bf16 v162, v24, v12, 0
    v_dot2_f32_bf16 v163, v28, v12, 0
    v_dot2_f32_bf16 v164, v32, v12, 0
    v_dot2_f32_bf16 v165, v36, v12, 0
    v_dot2_f32_bf16 v166, v40, v12, 0
    v_dot2_f32_bf16 v167, v44, v12, 0
    v_dot2_f32_bf16 v168, v48, v12, 0
    v_dot2_f32_bf16 v169, v52, v12, 0
    v_dot2_f32_bf16 v170, v56, v12, 0
    v_dot2_f32_bf16 v171, v60, v12, 0
    v_dot2_f32_bf16 v172, v64, v12, 0
    v_dot2_f32_bf16 v173, v68, v12, 0
    v_dot2_f32_bf16 v174, v72, v12, 0
    v_dot2_f32_bf16 v175, v76, v12, 0
    v_dot2c_f32_bf16 v160, v17, v13
    v_dot2c_f32_bf16 v161, v21, v13
    v_dot2c_f32_bf16 v162, v25, v13
    v_dot2c_f32_bf16 v163, v29, v13
    v_dot2c_f32_bf16 v164, v33, v13
    v_dot2c_f32_bf16 v165, v37, v13
    v_dot2c_f32_bf16 v166, v41, v13
    v_dot2c_f32_bf16 v167, v45, v13
    v_dot2c_f32_bf16 v168, v49, v13
    v_dot2c_f32_bf16 v169, v53, v13
    v_dot2c_f32_bf16 v170, v57, v13
    v_dot2c_f32_bf16 v171, v61, v13
    v_dot2c_f32_bf16 v172, v65, v13
    v_dot2c_f32_bf16 v173, v69, v13
    v_dot2c_f32_bf16 v174, v73, v13
    v_dot2c_f32_bf16 v175, v77, v13
    global_load_dwordx4 v[124:127], v4, s[20:21] offset:1152 nt
    v_dot2c_f32_bf16 v160, v18, v14
    v_dot2c_f32_bf16 v161, v22, v14
    v_dot2c_f32_bf16 v162, v26, v14
    v_dot2c_f32_bf16 v163, v30, v14
    v_dot2c_f32_bf16 v164, v34, v14
    v_dot2c_f32_bf16 v165, v38, v14
    v_dot2c_f32_bf16 v166, v42, v14
    v_dot2c_f32_bf16 v167, v46, v14
    v_dot2c_f32_bf16 v168, v50, v14
    v_dot2c_f32_bf16 v169, v54, v14
    v_dot2c_f32_bf16 v170, v58, v14
    v_dot2c_f32_bf16 v171, v62, v14
    v_dot2c_f32_bf16 v172, v66, v14
    v_dot2c_f32_bf16 v173, v70, v14
    v_dot2c_f32_bf16 v174, v74, v14
    v_dot2c_f32_bf16 v175, v78, v14
    v_dot2c_f32_bf16 v160, v19, v15
    v_dot2c_f32_bf16 v161, v23, v15
    v_dot2c_f32_bf16 v162, v27, v15
    v_dot2c_f32_bf16 v163, v31, v15
    v_dot2c_f32_bf16 v164, v35, v15
    v_dot2c_f32_bf16 v165, v39, v15
    v_dot2c_f32_bf16 v166, v43, v15
    v_dot2c_f32_bf16 v167, v47, v15
    v_dot2c_f32_bf16 v168, v51, v15
    v_dot2c_f32_bf16 v169, v55, v15
    v_dot2c_f32_bf16 v170, v59, v15
    v_dot2c_f32_bf16 v171, v63, v15
    v_dot2c_f32_bf16 v172, v67, v15
    v_dot2c_f32_bf16 v173, v71, v15
    v_dot2c_f32_bf16 v174, v75, v15
    v_dot2c_f32_bf16 v175, v79, v15
    global_load_dwordx4 v[128:131], v4, s[20:21] offset:1536 nt
    v_add_f32_dpp v144, v160, v160 row_half_mirror row_mask:0xf bank_mask:0x5
    v_add_f32_dpp v145, v161, v161 row_half_mirror row_mask:0xf bank_mask:0x5
    v_add_f32_dpp v146, v162, v162 row_half_mirror row_mask:0xf bank_mask:0x5
    v_add_f32_dpp v147, v163, v163 row_half_mirror row_mask:0xf bank_mask:0x5
    v_add_f32_dpp v148, v164, v164 row_half_mirror row_mask:0xf bank_mask:0x5
    v_add_f32_dpp v149, v165, v165 row_half_mirror row_mask:0xf bank_mask:0x5
    v_add_f32_dpp v150, v166, v166 row_half_mirror row_mask:0xf bank_mask:0x5
    v_add_f32_dpp v151, v167, v167 row_half_mirror row_mask:0xf bank_mask:0x5
    v_add_f32_dpp v144, v168, v168 row_half_mirror row_mask:0xf bank_mask:0xa
    v_add_f32_dpp v145, v169, v169 row_half_mirror row_mask:0xf bank_mask:0xa
    v_add_f32_dpp v146, v170, v170 row_half_mirror row_mask:0xf bank_mask:0xa
    v_add_f32_dpp v147, v171, v171 row_half_mirror row_mask:0xf bank_mask:0xa
    v_add_f32_dpp v148, v172, v172 row_half_mirror row_mask:0xf bank_mask:0xa
L_t4:
    s_cbranch_execz L_back2
    v_add_f32_dpp v149, v173, v173 row_half_mirror row_mask:0xf bank_mask:0xa
    v_add_f32_dpp v150, v174, v174 row_half_mirror row_mask:0xf bank_mask:0xa
    v_add_f32_dpp v151, v175, v175 row_half_mirror row_mask:0xf bank_mask:0xa
    v_add_f32_dpp v144, v144, v144 quad_perm:[1,0,3,2] row_mask:0xf bank_mask:0xf
    v_add_f32_dpp v145, v145, v145 quad_perm:[1,0,3,2] row_mask:0xf bank_mask:0xf
    v_add_f32_dpp v146, v146, v146 quad_perm:[1,0,3,2] row_mask:0xf bank_mask:0xf
    v_add_f32_dpp v147, v147, v147 quad_perm:[1,0,3,2] row_mask:0xf bank_mask:0xf
    v_add_f32_dpp v148, v148, v148 quad_perm:[1,0,3,2] row_mask:0xf bank_mask:0xf
    v_add_f32_dpp v149, v149, v149 quad_perm:[1,0,3,2] row_mask:0xf bank_mask:0xf
    v_add_f32_dpp v150, v150, v150 quad_perm:[1,0,3,2] row_mask:0xf bank_mask:0xf
    v_add_f32_dpp v151, v151, v151 quad_perm:[1,0,3,2] row_mask:0xf bank_mask:0xf
    v_add_f32_dpp v144, v144, v144 quad_perm:[2,3,0,1] row_mask:0xf bank_mask:0xf
    v_add_f32_dpp v145, v145, v145 quad_perm:[2,3,0,1] row_mask:0xf bank_mask:0xf
    v_add_f32_dpp v146, v146, v146 quad_perm:[2,3,0,1] row_mask:0xf bank_mask:0xf
    v_add_f32_dpp v147, v147, v147 quad_perm:[2,3,0,1] row_mask:0xf bank_mask:0xf
    v_add_f32_dpp v148, v148, v148 quad_perm:[2,3,0,1] row_mask:0xf bank_mask:0xf
    v_add_f32_dpp v149, v149, v149 quad_perm:[2,3,0,1] row_mask:0xf bank_mask:0xf
    v_add_f32_dpp v150, v150, v150 quad_perm:[2,3,0,1] row_mask:0xf bank_mask:0xf
    v_add_f32_dpp v151, v151, v151 quad_perm:[2,3,0,1] row_mask:0xf bank_mask:0xf
    s_mov_b32 exec_lo, 0x11111111
    s_mov_b32 exec_hi, 0x11111111
    ds_write_b128 v179, v[144:147]
    ds_write_b128 v179, v[148:151] offset:16
    s_mov_b64 exec, 1
    ds_add_u32 v183, v184 offset:1544
    s_mov_b64 exec, -1
    global_load_dwordx4 v[132:135], v4, s[20:21] offset:1920 nt
L_sc:
    ds_read_b32 v16, v183 offset:1544
    ds_read_b64 v[18:19], v180
    ds_read_b64 v[20:21], v180 offset:512
    ds_read_b64 v[22:23], v180 offset:1024
    s_waitcnt lgkmcnt(3)
    v_readfirstlane_b32 s8, v16
    s_cmp_lt_u32 s8, 3
    s_waitcnt lgkmcnt(0)
    s_cbranch_scc1 L_sc
    global_load_dwordx4 v[136:139], v4, s[20:21] offset:2304 nt
    v_add_f32 v18, v18, v20
    v_add_f32 v19, v19, v21
    v_add_f32 v18, v18, v22
    v_add_f32 v19, v19, v23
    v_cvt_pk_bf16_f32 v18, v18, v19
    v_and_b32 v19, 0xffff0000, v18
    v_lshlrev_b32 v18, 16, v18
    v_mul_f32 v18, 0x3d93cd3a, v18
    v_mul_f32 v19, 0x3d93cd3a, v19
    v_cvt_pk_bf16_f32 v18, v18, v19
    v_and_b32 v19, 0xffff0000, v18
    v_lshlrev_b32 v18, 16, v18
    v_mul_f32 v18, 0x3fb8aa3b, v18
    v_mul_f32 v19, 0x3fb8aa3b, v19
    v_max_f32 v188, v18, v19
    s_nop 1
    v_max_f32_dpp v188, v188, v188 quad_perm:[1,0,3,2] row_mask:0xf bank_mask:0xf
    s_nop 1
    v_max_f32_dpp v188, v188, v188 quad_perm:[2,3,0,1] row_mask:0xf bank_mask:0xf
    s_nop 1
    v_max_f32_dpp v188, v188, v188 row_half_mirror row_mask:0xf bank_mask:0xf
    s_nop 1
    v_max_f32_dpp v188, v188, v188 row_ror:8 row_mask:0xf bank_mask:0xf
    v_mov_b32 v20, v188
    s_nop 1
    v_permlane16_swap_b32 v188, v20
    v_max_f32 v188, v188, v20
    v_mov_b32 v20, v188
    s_nop 1
    v_permlane32_swap_b32 v188, v20
    v_max_f32 v188, v188, v20
    global_load_dwordx4 v[140:143], v4, s[20:21] offset:2688 nt
    s_barrier
    v_sub_f32 v18, v18, v188
    v_sub_f32 v19, v19, v188
    v_exp_f32 v18, v18
    v_exp_f32 v19, v19
    v_cvt_pk_bf16_f32 v20, v18, v18
    v_cvt_pk_bf16_f32 v21, v19, v19
    ds_write_b64 v181, v[20:21] offset:2048
    ds_read_b128 v[160:163], v182 offset:2048
    ds_read_b128 v[164:167], v182 offset:2064
    ds_read_b128 v[168:171], v182 offset:2080
    ds_read_b128 v[172:175], v182 offset:2096
    v_add_f32 v189, v18, v19
    s_nop 1
    v_add_f32_dpp v189, v189, v189 quad_perm:[1,0,3,2] row_mask:0xf bank_mask:0xf
    s_nop 1
    v_add_f32_dpp v189, v189, v189 quad_perm:[2,3,0,1] row_mask:0xf bank_mask:0xf
    s_nop 1
    v_add_f32_dpp v189, v189, v189 row_half_mirror row_mask:0xf bank_mask:0xf
    s_nop 1
    v_add_f32_dpp v189, v189, v189 row_ror:8 row_mask:0xf bank_mask:0xf
    v_mov_b32 v20, v189
    s_nop 1
    v_permlane16_swap_b32 v189, v20
    v_add_f32 v189, v189, v20
    v_mov_b32 v20, v189
    s_nop 1
    v_permlane32_swap_b32 v189, v20
    v_add_f32 v189, v189, v20
    v_cndmask_b32 v190, v188, v189, s[52:53]
    v_mov_b32 v191, s42
    s_waitcnt lgkmcnt(0)
    v_and_b32 v16, v160, v8
    v_and_b32 v17, v160, v9
    v_and_b32 v18, v160, v10
    v_and_b32 v19, v160, v11
    v_and_b32 v20, v161, v8
    v_and_b32 v21, v161, v9
    v_and_b32 v22, v161, v10
    v_and_b32 v23, v161, v11
    v_mfma_f32_16x16x32_bf16 v[12:15], v[16:19], v[80:83], 0
    v_and_b32 v24, v162, v8
    v_and_b32 v25, v162, v9
    v_and_b32 v26, v162, v10
    v_and_b32 v27, v162, v11
    v_mfma_f32_16x16x32_bf16 v[12:15], v[20:23], v[84:87], v[12:15]
    v_and_b32 v28, v163, v8
    v_and_b32 v29, v163, v9
    v_and_b32 v30, v163, v10
    v_and_b32 v31, v163, v11
    v_mfma_f32_16x16x32_bf16 v[12:15], v[24:27], v[88:91], v[12:15]
    v_and_b32 v32, v164, v8
    v_and_b32 v33, v164, v9
    v_and_b32 v34, v164, v10
    v_and_b32 v35, v164, v11
    s_waitcnt vmcnt(14)
    v_mfma_f32_16x16x32_bf16 v[12:15], v[28:31], v[92:95], v[12:15]
    v_and_b32 v36, v165, v8
    v_and_b32 v37, v165, v9
    v_and_b32 v38, v165, v10
    v_and_b32 v39, v165, v11
    s_waitcnt vmcnt(13)
    v_mfma_f32_16x16x32_bf16 v[12:15], v[32:35], v[96:99], v[12:15]
    v_and_b32 v40, v166, v8
    v_and_b32 v41, v166, v9
    v_and_b32 v42, v166, v10
    v_and_b32 v43, v166, v11
    s_waitcnt vmcnt(12)
    v_mfma_f32_16x16x32_bf16 v[12:15], v[36:39], v[100:103], v[12:15]
    v_and_b32 v44, v167, v8
    v_and_b32 v45, v167, v9
    v_and_b32 v46, v167, v10
    v_and_b32 v47, v167, v11
    s_waitcnt vmcnt(9)
    v_mfma_f32_16x16x32_bf16 v[12:15], v[40:43], v[104:107], v[12:15]
    v_and_b32 v48, v168, v8
    v_and_b32 v49, v168, v9
    v_and_b32 v50, v168, v10
    v_and_b32 v51, v168, v11
    s_waitcnt vmcnt(8)
    v_mfma_f32_16x16x32_bf16 v[12:15], v[44:47], v[108:111], v[12:15]
    v_and_b32 v52, v169, v8
    v_and_b32 v53, v169, v9
    v_and_b32 v54, v169, v10
    v_and_b32 v55, v169, v11
    v_and_b32 v56, v170, v8
    v_and_b32 v57, v170, v9
    v_and_b32 v58, v170, v10
    v_and_b32 v59, v170, v11
    v_and_b32 v60, v171, v8
    v_and_b32 v61, v171, v9
    v_and_b32 v62, v171, v10
    v_and_b32 v63, v171, v11
    v_and_b32 v64, v172, v8
    v_and_b32 v65, v172, v9
    v_and_b32 v66, v172, v10
    v_and_b32 v67, v172, v11
    v_and_b32 v68, v173, v8
    v_and_b32 v69, v173, v9
    v_and_b32 v70, v173, v10
    v_and_b32 v71, v173, v11
    v_and_b32 v72, v174, v8
    v_and_b32 v73, v174, v9
    v_and_b32 v74, v174, v10
    v_and_b32 v75, v174, v11
    v_and_b32 v76, v175, v8
    v_and_b32 v77, v175, v9
    v_and_b32 v78, v175, v10
    v_and_b32 v79, v175, v11
    s_waitcnt vmcnt(7)
    v_mfma_f32_16x16x32_bf16 v[12:15], v[48:51], v[112:115], v[12:15]
    s_waitcnt vmcnt(6)
    v_mfma_f32_16x16x32_bf16 v[12:15], v[52:55], v[116:119], v[12:15]
    s_waitcnt vmcnt(5)
    v_mfma_f32_16x16x32_bf16 v[12:15], v[56:59], v[120:123], v[12:15]
    s_waitcnt vmcnt(4)
    v_mfma_f32_16x16x32_bf16 v[12:15], v[60:63], v[124:127], v[12:15]
    s_waitcnt vmcnt(3)
    v_mfma_f32_16x16x32_bf16 v[12:15], v[64:67], v[128:131], v[12:15]
    s_waitcnt vmcnt(2)
    v_mfma_f32_16x16x32_bf16 v[12:15], v[68:71], v[132:135], v[12:15]
    s_waitcnt vmcnt(1)
    v_mfma_f32_16x16x32_bf16 v[12:15], v[72:75], v[136:139], v[12:15]
    s_waitcnt vmcnt(0)
    v_mfma_f32_16x16x32_bf16 v[12:15], v[76:79], v[140:143], v[12:15]
    s_nop 7
    v_permlane32_swap_b32 v12, v144
    v_permlane32_swap_b32 v13, v145
    v_permlane32_swap_b32 v14, v146
    v_permlane32_swap_b32 v15, v147
    v_add_f32_dpp v12, v144, v12 row_ror:8 row_mask:0xf bank_mask:0xf
L_t5:
    s_cbranch_execz L_back2
    v_add_f32_dpp v13, v145, v13 row_ror:8 row_mask:0xf bank_mask:0xf
    v_add_f32_dpp v14, v146, v14 row_ror:8 row_mask:0xf bank_mask:0xf
    v_add_f32_dpp v15, v147, v15 row_ror:8 row_mask:0xf bank_mask:0xf
    v_cvt_pk_bf16_f32 v188, v12, v13
    v_cvt_pk_bf16_f32 v189, v14, v15
    s_mov_b64 exec, 0x00ff00ff
    s_cmp_lg_u64 s[48:49], 0
    s_cbranch_scc1 L_slowpub
    global_store_dwordx4 v6, v[188:191], s[40:41]
L_pubdone:
    s_barrier
L_fin:
L_end:
    s_endpgm
L_slowpub:
    global_store_dwordx4 v6, v[188:191], s[40:41] sc1
    s_branch L_pubdone
.section .rodata,"a"
.p2align 6
.amdhsa_kernel gated_mix__sliding_block_cached__glu_gated_geglu__decode_kernel
  .amdhsa_next_free_vgpr 200
  .amdhsa_next_free_sgpr 102
  .amdhsa_accum_offset 200
  .amdhsa_group_segment_fixed_size 0
  .amdhsa_kernarg_size 104
  .amdhsa_user_sgpr_count 2
  .amdhsa_user_sgpr_kernarg_segment_ptr 1
  .amdhsa_system_sgpr_workgroup_id_x 1
  .amdhsa_float_denorm_mode_32 3
.end_amdhsa_kernel
```
